```python
import torch

def _softmax(x, axis=-1):
    return torch.softmax(x, dim=axis)
def _gelu(x):
    return torch.nn.functional.gelu(x, approximate="tanh")
def _silu(x):
    return torch.nn.functional.silu(x)
def _sigmoid(x):
    return torch.sigmoid(x)
def _layernorm(x, axis=-1, eps=1e-5):
    m = x.mean(dim=axis, keepdim=True)
    v = x.var(dim=axis, keepdim=True, unbiased=False)
    return (x - m) / torch.sqrt(v + eps)
def _scatter_add(tgt, idx, src, axis=0):
    return tgt.clone().index_add_(axis, idx, src)
def _segment_sum(src, seg, n):
    out = torch.zeros((n,) + src.shape[1:], dtype=src.dtype)
    return out.index_add_(0, seg, src)
def _pad(x, pw):
    flat = tuple(v for pair in reversed(pw) for v in pair)
    return torch.nn.functional.pad(x, flat)

kernel_name = 'standalone__swiglu_ffn__decode'

def setup_inputs():

    _w = (lambda a: (lambda t: t.to(torch.bfloat16) if t.is_floating_point() else t)(torch.as_tensor(a)))
    B, S, D, F = 4, 1, 1024, 3584
    return {
        "x": _w((lambda *s: torch.randn(*s, dtype=torch.bfloat16) * 0.05)(B, S, D)),
        "w_gate": _w((lambda *s: torch.randn(*s, dtype=torch.bfloat16) * 0.05)(D, F)),
        "w_up": _w((lambda *s: torch.randn(*s, dtype=torch.bfloat16) * 0.05)(D, F)),
        "w_down": _w((lambda *s: torch.randn(*s, dtype=torch.bfloat16) * 0.05)(F, D)),
    }

def reference(x, w_gate, w_up, w_down):
    g = _silu(x @ w_gate)
    u = x @ w_up
    return (g * u) @ w_down
```

```asm
; @launch grid=(256,1,1) block=(256,1,1) lds=74752
.amdgcn_target "amdgcn-amd-amdhsa--gfx950"
.text
.globl standalone__swiglu_ffn__decode_kernel
.p2align 12
.fill 832, 4, 0xbf810000
.p2align 8
.type standalone__swiglu_ffn__decode_kernel,@function
standalone__swiglu_ffn__decode_kernel:
    s_load_dwordx8 s[4:11], s[0:1], 0
    s_cmp_ge_u32 s2, 16
    s_cbranch_scc1 L_nopf
    s_getpc_b64 s[56:57]
L_pc:
    v_lshlrev_b32 v20, 4, v0
    v_min_u32 v20, L_last-L_pc, v20
    global_load_dword v25, v20, s[56:57]
L_nopf:
    s_load_dwordx2 s[44:45], s[0:1], 48
    s_load_dwordx2 s[12:13], s[0:1], 32
    v_lshrrev_b32 v1, 6, v0
    s_and_b32 s20, s2, 7
    s_lshr_b32 s23, s2, 5
    v_readfirstlane_b32 s3, v1
    s_cmp_ge_u32 s23, 8
    s_cbranch_scc1 L_end
    v_lshrrev_b32 v4, 3, v0
    s_cmp_eq_u32 s23, 0
    s_cselect_b32 s16, 3, s23
    v_lshrrev_b32 v5, 4, v0
    s_cmp_eq_u32 s20, 3
    s_cselect_b32 s17, 0, s20
    s_lshl3_add_u32 s22, s23, s20
    s_mov_b32 s28, 0x00010101
    s_mov_b32 s29, 0x7e010101
    s_bitcmp1_b64 s[28:29], s22
    s_cbranch_scc0 L_nosw
    s_cmp_eq_u32 s20, 0
    s_cselect_b32 s23, 7, s17
    s_cselect_b32 s22, s16, 0
L_nosw:
    s_and_b32 s16, s22, 7
    v_and_b32 v6, 2, v4
    s_cmp_eq_u32 s23, 7
    s_cselect_b32 s22, 1, 0
    s_cselect_b32 s23, 3, s23
    v_and_b32 v5, 4, v5
    s_bfe_u32 s24, s2, 0x10004
    s_lshl1_add_u32 s30, s24, s22
    v_and_b32 v7, 7, v0
    s_lshl3_add_u32 s25, s16, s23
    s_lshl3_add_u32 s27, s23, 7
    s_cmp_eq_u32 s16, 7
    s_cselect_b32 s25, s27, s25
    v_bitop3_b32 v6, v6, v5, v7 bitop3:0x96
    s_mul_i32 s31, s30, 14336
    s_add_u32 s31, s31, s25
    v_lshlrev_b32 v6, 4, v6
    s_lshl_b32 s31, s31, 7
    s_cmp_eq_u32 s23, 3
    s_cselect_b32 s26, 8, 0
    s_movk_i32 s28, 7168
    s_lshl2_add_u32 s32, s26, s3
    v_mad_u32_u24 v3, v4, s28, v6
    s_lshl_b32 s32, s32, 10
    s_mov_b32 s38, 7340032
    s_mov_b32 m0, s32
    s_mov_b32 s39, 0x20000
    s_mov_b32 s53, 229376
    s_bitcmp1_b32 s2, 3
    s_waitcnt lgkmcnt(0)
    s_cselect_b32 s36, s8, s6
    s_cselect_b32 s37, s9, s7
    buffer_load_dwordx4 v3, s[36:39], s31 offen nt lds
    s_add_u32 s32, s32, 4096
    s_mov_b32 m0, s32
    s_add_u32 s31, s31, s53
    v_and_b32 v10, 3, v0
    v_lshrrev_b32 v5, 2, v0
    s_lshl2_add_u32 s52, s3, s26
    v_lshlrev_b32 v8, 11, v10
    s_lshl_b32 s52, s52, 8
    v_lshl_add_u32 v8, v5, 4, v8
    s_add_u32 s52, s52, 65536
    buffer_load_dwordx4 v3, s[36:39], s31 offen nt lds
    s_add_u32 s32, s32, 4096
    s_mov_b32 m0, s52
    s_add_u32 s31, s31, s53
    s_lshl_b32 s30, s30, 9
    s_mov_b32 s6, 8192
    s_mov_b32 s7, 0x20000
    s_sub_u32 s54, 14, s26
    buffer_load_dwordx4 v8, s[4:7], s30 offen lds
    s_mov_b32 m0, s32
    s_load_dword s34, s[44:45], 0
L_iss:
    buffer_load_dwordx4 v3, s[36:39], s31 offen nt lds
    s_add_u32 s32, s32, 4096
    s_mov_b32 m0, s32
    s_add_u32 s31, s31, s53
    s_sub_u32 s54, s54, 1
    s_cmp_lg_u32 s54, 0
    s_cbranch_scc1 L_iss
    s_lshr_b32 s21, s2, 3
    v_and_b32 v2, 63, v0
    v_lshlrev_b32 v21, 3, v0
    v_and_b32 v5, 15, v5
    v_and_b32 v4, 7, v4
    v_lshlrev_b32 v15, 4, v2
    s_and_b32 s27, s3, 1
    s_mov_b32 s46, 0x200000
    s_mov_b32 s47, 0x20000
    s_add_u32 s33, s16, 56
    s_cmp_eq_u32 s22, 1
    s_cselect_b32 s33, s33, s25
    s_and_b32 s35, s21, 3
    s_lshl_b32 s35, s35, 16
    s_lshl2_add_u32 s33, s33, s3
    s_lshl_b32 s33, s33, 8
    s_add_u32 s35, s35, s33
    s_add_u32 s35, s35, 589824
    v_lshrrev_b32 v9, 4, v2
    v_and_b32 v8, 3, v5
    v_lshrrev_b32 v11, 1, v8
    v_and_b32 v12, 1, v9
    v_lshl_or_b32 v11, v12, 1, v11
    v_lshlrev_b32 v14, 3, v10
    v_lshl_add_u32 v14, v8, 7, v14
    v_lshrrev_b32 v13, 1, v9
    v_lshl_or_b32 v13, s27, 1, v13
    v_xor_b32 v13, v13, v11
    v_lshl_add_u32 v13, v13, 5, v14
    v_lshl_add_u32 v13, v12, 10, v13
    s_lshr_b32 s28, s3, 1
    v_lshl_add_u32 v13, s28, 11, v13
    s_lshl_b32 s32, s3, 10
    s_mov_b32 m0, s32
    v_xor_b32 v11, s3, v11
    v_lshl_add_u32 v11, v11, 5, v14
    v_lshl_add_u32 v11, v9, 10, v11
    v_lshlrev_b32 v14, 4, v10
    v_lshl_add_u32 v1, v12, 6, v14
    v_add_u32 v1, 71680, v1
    v_lshl_add_u32 v12, v9, 6, v14
    v_add_u32 v12, 65536, v12
    v_lshl_add_u32 v0, v5, 11, v14
    v_lshl_add_u32 v14, v4, 11, v6
    v_mov_b64 v[16:17], 0
    v_mov_b64 v[18:19], 0
    v_mov_b64 v[96:97], 0
    v_mov_b64 v[98:99], 0
    v_mov_b64 v[100:101], 0
    v_mov_b64 v[102:103], 0
    v_mov_b64 v[104:105], 0
    v_mov_b64 v[106:107], 0
    v_mov_b64 v[108:109], 0
    v_mov_b64 v[110:111], 0
    v_mov_b64 v[112:113], 0
    v_mov_b64 v[114:115], 0
    v_mov_b64 v[116:117], 0
    v_mov_b64 v[118:119], 0
    v_mov_b64 v[120:121], 0
    v_mov_b64 v[122:123], 0
    s_mul_i32 s55, s21, 14
    s_add_u32 s55, s55, s27
    s_lshl_b32 s55, s55, 7
    s_lshl1_add_u32 s33, s20, s28
    s_add_u32 s55, s55, s33
    s_lshl_b32 s55, s55, 7
    s_mov_b64 s[36:37], s[10:11]
    s_mov_b64 s[40:41], s[12:13]
    s_mov_b32 s42, 8192
    s_mov_b32 s43, 0x20000
    s_lshl2_add_u32 s33, s20, s3
    s_lshl_b32 s33, s33, 8
    s_add_u32 s33, s33, s21
    s_lshl_b32 s33, s33, 6
    s_add_u32 s33, s33, 4096
    s_mov_b32 s48, 0x07060501
    s_mov_b32 s49, 0x07060502
    s_mov_b32 s50, 0x07060503
    s_mov_b32 s52, 0x0c04000c
    s_mov_b32 s60, 0x0f0f0f0f
    s_mov_b32 s61, 0xf0f0f0f0
    v_and_b32 v8, 15, v2
    v_lshlrev_b32 v3, 16, v9
    v_lshl_add_u32 v3, v8, 4, v3
    v_lshrrev_b32 v6, 3, v8
    v_lshlrev_b32 v6, 6, v6
    v_lshl_add_u32 v6, v9, 4, v6
    v_lshl_add_u32 v6, v7, 1, v6
    s_lshl_b32 s28, s3, 7
    s_add_u32 s28, s28, 71680
    v_add_u32 v6, s28, v6
    v_lshlrev_b32 v5, 11, v9
    v_lshl_add_u32 v5, v10, 1, v5
    s_lshl_b32 s18, s20, 5
    s_add_u32 s18, s18, s21
    s_lshl_b32 s19, s18, 3
    s_lshl_b32 s18, s18, 11
    s_add_u32 s18, s18, 4096
    s_mov_b32 s51, 2097152
    s_mul_i32 s22, s21, 7
    s_add_u32 s22, s22, s3
    s_getreg_b32 s14, hwreg(HW_REG_XCC_ID, 0, 4)
    s_waitcnt lgkmcnt(0)
    s_add_u32 s34, s34, 1
    s_add_u32 s14, s14, s34
    v_mov_b32 v31, s34
    s_add_u32 s14, s14, 1
    s_lshl_b32 s28, s22, 8
    s_add_u32 s4, s28, 589824
    s_lshr_b32 s28, s22, 2
    s_and_b32 s29, s28, 7
    s_lshr_b32 s11, s28, 3
    s_cmp_eq_u32 s28, 31
    s_cselect_b32 s29, 3, s29
    s_cselect_b32 s11, 7, s11
    s_and_b32 s28, s22, 3
    s_lshl2_add_u32 s11, s11, s28
    s_lshl_b32 s11, s11, 8
    s_add_u32 s11, s11, 647168
    s_cmp_eq_u32 s29, 3
    s_cselect_b32 s5, s11, 0
    s_cselect_b32 s8, s34, 0
    s_add_u32 s22, s22, 4
    s_lshl_b32 s28, s22, 8
    s_add_u32 s6, s28, 589824
    s_lshr_b32 s28, s22, 2
    s_and_b32 s29, s28, 7
    s_lshr_b32 s11, s28, 3
    s_cmp_eq_u32 s28, 31
    s_cselect_b32 s29, 3, s29
    s_cselect_b32 s11, 7, s11
    s_and_b32 s28, s22, 3
    s_lshl2_add_u32 s11, s11, s28
    s_lshl_b32 s11, s11, 8
    s_add_u32 s11, s11, 647168
    s_cmp_eq_u32 s29, 3
    s_cselect_b32 s7, s11, 0
    s_cselect_b32 s10, s34, 0
    s_cmp_eq_u32 s3, 3
    s_cselect_b32 s6, 2130706432, s6
    s_cselect_b32 s7, 0, s7
    s_cselect_b32 s9, 0, s34
    s_cselect_b32 s10, 0, s10
    s_cmp_eq_u32 s26, 8
    s_cselect_b32 s29, 38, 28
    s_mul_i32 s28, s26, s20
    s_cmp_lg_u32 s28, 0
    s_cselect_b64 vcc, -1, 0
    s_cselect_b32 s29, 40, s29
    s_cmp_eq_u32 s26, 8
    s_cbranch_scc1 L_gC
    s_waitcnt vmcnt(8)
    s_barrier
    ds_read_b64_tr_b16 v[36:37], v11 offset:0
    ds_read_b64_tr_b16 v[38:39], v11 offset:512
    ds_read_b128 v[32:35], v12 offset:0
    ds_read_b64_tr_b16 v[44:45], v11 offset:4096
    ds_read_b64_tr_b16 v[46:47], v11 offset:4608
    ds_read_b128 v[40:43], v12 offset:256
    ds_read_b64_tr_b16 v[52:53], v11 offset:8192
    ds_read_b64_tr_b16 v[54:55], v11 offset:8704
    ds_read_b128 v[48:51], v12 offset:512
    ds_read_b64_tr_b16 v[60:61], v11 offset:12288
    ds_read_b64_tr_b16 v[62:63], v11 offset:12800
    ds_read_b128 v[56:59], v12 offset:768
    ds_read_b64_tr_b16 v[68:69], v11 offset:16384
    ds_read_b64_tr_b16 v[70:71], v11 offset:16896
    ds_read_b128 v[64:67], v12 offset:1024
    ds_read_b64_tr_b16 v[76:77], v11 offset:20480
    ds_read_b64_tr_b16 v[78:79], v11 offset:20992
    ds_read_b128 v[72:75], v12 offset:1280
    ds_read_b64_tr_b16 v[84:85], v11 offset:24576
    ds_read_b64_tr_b16 v[86:87], v11 offset:25088
    ds_read_b128 v[80:83], v12 offset:1536
    ds_read_b64_tr_b16 v[92:93], v11 offset:28672
    ds_read_b64_tr_b16 v[94:95], v11 offset:29184
    ds_read_b128 v[88:91], v12 offset:1792
    s_waitcnt lgkmcnt(0)
    v_mfma_f32_16x16x32_bf16 v[16:19], v[32:35], v[36:39], v[16:19]
    v_mfma_f32_16x16x32_bf16 v[16:19], v[40:43], v[44:47], v[16:19]
    v_mfma_f32_16x16x32_bf16 v[16:19], v[48:51], v[52:55], v[16:19]
    v_mfma_f32_16x16x32_bf16 v[16:19], v[56:59], v[60:63], v[16:19]
    v_mfma_f32_16x16x32_bf16 v[16:19], v[64:67], v[68:71], v[16:19]
    v_mfma_f32_16x16x32_bf16 v[16:19], v[72:75], v[76:79], v[16:19]
    v_mfma_f32_16x16x32_bf16 v[16:19], v[80:83], v[84:87], v[16:19]
    v_mfma_f32_16x16x32_bf16 v[16:19], v[88:91], v[92:95], v[16:19]
L_gC:
    s_waitcnt vmcnt(5)
    s_barrier
    s_cbranch_vccnz L_lt0
    buffer_load_dwordx4 v14, s[36:39], s55 offen nt lds
    s_add_u32 s32, s32, 4096
    s_mov_b32 m0, s32
    s_add_u32 s55, s55, 32768
    buffer_load_dwordx4 v14, s[36:39], s55 offen nt lds
    s_add_u32 s32, s32, 4096
    s_mov_b32 m0, s32
    s_add_u32 s55, s55, 32768
L_lt0:
    ds_read_b64_tr_b16 v[36:37], v11 offset:32768
    ds_read_b64_tr_b16 v[38:39], v11 offset:33280
    ds_read_b128 v[32:35], v12 offset:2048
    ds_read_b64_tr_b16 v[44:45], v11 offset:36864
    ds_read_b64_tr_b16 v[46:47], v11 offset:37376
    ds_read_b128 v[40:43], v12 offset:2304
    ds_read_b64_tr_b16 v[52:53], v11 offset:40960
    ds_read_b64_tr_b16 v[54:55], v11 offset:41472
    ds_read_b128 v[48:51], v12 offset:2560
    s_waitcnt lgkmcnt(0)
    v_mfma_f32_16x16x32_bf16 v[16:19], v[32:35], v[36:39], v[16:19]
    v_mfma_f32_16x16x32_bf16 v[16:19], v[40:43], v[44:47], v[16:19]
    v_mfma_f32_16x16x32_bf16 v[16:19], v[48:51], v[52:55], v[16:19]
    s_cbranch_vccnz L_lt1
    s_waitcnt vmcnt(6)
    buffer_load_dwordx4 v14, s[36:39], s55 offen nt lds
    s_add_u32 s32, s32, 4096
    s_mov_b32 m0, s32
    s_add_u32 s55, s55, 32768
    s_branch L_lj1
L_lt1:
    s_waitcnt vmcnt(4)
L_lj1:
    s_barrier
    ds_read_b64_tr_b16 v[36:37], v11 offset:45056
    ds_read_b64_tr_b16 v[38:39], v11 offset:45568
    ds_read_b128 v[32:35], v12 offset:2816
    s_waitcnt lgkmcnt(0)
    v_mfma_f32_16x16x32_bf16 v[16:19], v[32:35], v[36:39], v[16:19]
    s_cbranch_vccz L_lj2
    s_waitcnt vmcnt(3)
L_lj2:
    s_waitcnt vmcnt(6)
    s_barrier
    ds_read_b64_tr_b16 v[36:37], v11 offset:49152
    ds_read_b64_tr_b16 v[38:39], v11 offset:49664
    ds_read_b128 v[32:35], v12 offset:3072
    s_waitcnt lgkmcnt(0)
    v_mfma_f32_16x16x32_bf16 v[16:19], v[32:35], v[36:39], v[16:19]
    s_cbranch_vccz L_lj3
    s_waitcnt vmcnt(2)
L_lj3:
    s_waitcnt vmcnt(5)
    s_barrier
    ds_read_b64_tr_b16 v[36:37], v11 offset:53248
    ds_read_b64_tr_b16 v[38:39], v11 offset:53760
    ds_read_b128 v[32:35], v12 offset:3328
    s_waitcnt lgkmcnt(0)
    v_mfma_f32_16x16x32_bf16 v[16:19], v[32:35], v[36:39], v[16:19]
    s_cbranch_vccz L_lj4
    s_waitcnt vmcnt(1)
L_lj4:
    s_waitcnt vmcnt(4)
    s_barrier
    ds_read_b64_tr_b16 v[36:37], v11 offset:57344
    ds_read_b64_tr_b16 v[38:39], v11 offset:57856
    ds_read_b128 v[32:35], v12 offset:3584
    s_waitcnt lgkmcnt(0)
    v_mfma_f32_16x16x32_bf16 v[16:19], v[32:35], v[36:39], v[16:19]
    s_cbranch_vccz L_lj5
    s_waitcnt vmcnt(0)
L_lj5:
    s_waitcnt vmcnt(3)
    s_barrier
    ds_read_b64_tr_b16 v[36:37], v11 offset:61440
    ds_read_b64_tr_b16 v[38:39], v11 offset:61952
    ds_read_b128 v[32:35], v12 offset:3840
    buffer_load_dwordx4 v14, s[36:39], s55 offen nt lds
    s_add_u32 s32, s32, 4096
    s_mov_b32 m0, s32
    s_add_u32 s55, s55, 32768
    s_waitcnt lgkmcnt(0)
    v_mfma_f32_16x16x32_bf16 v[16:19], v[32:35], v[36:39], v[16:19]
    s_mov_b64 exec, 0xffff
    s_nop 6
    v_perm_b32 v28, v16, v19, s48
    v_perm_b32 v29, v17, v19, s49
    v_perm_b32 v30, v18, v19, s50
    buffer_store_dwordx4 v[28:31], v15, s[44:47], s35 offen sc1
    s_mov_b64 exec, -1
    s_cbranch_vccz L_ln
    buffer_load_dwordx4 v14, s[36:39], s55 offen nt lds
    s_add_u32 s32, s32, 4096
    s_mov_b32 m0, s32
    s_add_u32 s55, s55, 32768
    buffer_load_dwordx4 v14, s[36:39], s55 offen nt lds
    s_add_u32 s32, s32, 4096
    s_mov_b32 m0, s32
    s_add_u32 s55, s55, 32768
    buffer_load_dwordx4 v14, s[36:39], s55 offen nt lds
    s_add_u32 s32, s32, 4096
    s_mov_b32 m0, s32
    s_add_u32 s55, s55, 32768
    s_cmp_lg_u32 s25, 31
    s_cbranch_scc1 L_ln
    s_waitcnt vmcnt(0)
    s_mov_b32 s29, 28
L_ln:
    buffer_load_dwordx4 v14, s[36:39], s55 offen nt lds
    s_add_u32 s32, s32, 4096
    s_mov_b32 m0, s32
    s_add_u32 s55, s55, 32768
    buffer_load_dwordx4 v14, s[36:39], s55 offen nt lds
    s_add_u32 s32, s32, 4096
    s_mov_b32 m0, s32
    s_add_u32 s55, s55, 32768
    buffer_load_dwordx4 v14, s[36:39], s55 offen nt lds
    s_add_u32 s32, s32, 4096
    s_mov_b32 m0, s32
    s_add_u32 s55, s55, 32768
    v_mov_b64 v[68:69], 0
    v_mov_b64 v[70:71], 0
    v_mov_b64 v[76:77], 0
    v_mov_b64 v[78:79], 0
.p2align 5
L_cw:
    s_getreg_b32 s58, hwreg(HW_REG_IB_STS, 0, 4)
    s_cmp_eq_u32 s58, 0
    s_cbranch_scc1 L_cwd
    s_sub_u32 s29, s29, 1
    s_cbranch_scc0 L_cw
L_cwd:
    buffer_load_dwordx4 v[64:67], v3, s[44:47], s4 offen sc1
    s_cmp_eq_u32 s5, 0
    buffer_load_dwordx4 v[72:75], v3, s[44:47], s6 offen sc1
    s_cbranch_scc1 L_ska0
    buffer_load_dwordx4 v[68:71], v3, s[44:47], s5 offen sc1
L_ska0:
    s_cmp_eq_u32 s7, 0
    s_cbranch_scc1 L_skb0
    buffer_load_dwordx4 v[76:79], v3, s[44:47], s7 offen sc1
L_skb0:
    s_waitcnt vmcnt(4)
    s_barrier
    buffer_load_dwordx2 v[22:23], v21, s[44:47], s18 offen
    buffer_load_ushort v24, v5, s[40:43], s19 offen
    ds_read_b64_tr_b16 v[32:33], v13 offset:0
    ds_read_b64_tr_b16 v[34:35], v13 offset:512
    ds_read_b64_tr_b16 v[36:37], v13 offset:4096
    ds_read_b64_tr_b16 v[38:39], v13 offset:4608
    ds_read_b64_tr_b16 v[40:41], v13 offset:8192
    ds_read_b64_tr_b16 v[42:43], v13 offset:8704
    ds_read_b64_tr_b16 v[44:45], v13 offset:12288
    ds_read_b64_tr_b16 v[46:47], v13 offset:12800
    ds_read_b64_tr_b16 v[48:49], v13 offset:16384
    ds_read_b64_tr_b16 v[50:51], v13 offset:16896
    s_waitcnt vmcnt(4)
    s_barrier
    ds_read_b64_tr_b16 v[52:53], v13 offset:20480
    ds_read_b64_tr_b16 v[54:55], v13 offset:20992
    ds_read_b64_tr_b16 v[56:57], v13 offset:24576
    ds_read_b64_tr_b16 v[58:59], v13 offset:25088
    s_waitcnt vmcnt(2)
L_gchk:
    v_xor_b32 v60, s34, v67
    v_xor_b32 v61, s9, v75
    v_xor_b32 v62, s8, v71
    v_xor_b32 v63, s10, v79
    v_or3_b32 v60, v60, v61, v62
    v_or_b32 v60, v60, v63
    v_cmp_ne_u32 vcc, 0, v60
    v_perm_b32 v67, v65, v64, s52
    v_perm_b32 v75, v73, v72, s52
    v_perm_b32 v71, v69, v68, s52
    v_perm_b32 v79, v77, v76, s52
    s_cbranch_vccnz L_g
L_gdone:
    v_lshl_or_b32 v67, v66, 24, v67
    v_lshl_or_b32 v75, v74, 24, v75
    v_lshl_or_b32 v71, v70, 24, v71
    v_lshl_or_b32 v79, v78, 24, v79
    v_pk_add_f32 v[64:65], v[64:65], v[68:69]
    v_pk_add_f32 v[66:67], v[66:67], v[70:71]
    v_pk_add_f32 v[72:73], v[72:73], v[76:77]
    v_pk_add_f32 v[74:75], v[74:75], v[78:79]
    v_permlane32_swap_b32 v64, v66
    v_permlane32_swap_b32 v65, v67
    v_permlane32_swap_b32 v72, v74
    v_permlane32_swap_b32 v73, v75
    v_pk_add_f32 v[64:65], v[64:65], v[66:67]
    v_pk_add_f32 v[72:73], v[72:73], v[74:75]
    s_nop 0
    v_permlane16_swap_b32 v64, v65
    v_permlane16_swap_b32 v72, v73
    v_cvt_pk_bf16_f32 v67, v65, v73
    v_cvt_pk_bf16_f32 v65, v64, v72
    v_lshlrev_b32 v64, 16, v65
    v_and_b32 v65, 0xffff0000, v65
    v_mul_f32 v68, 0xbfb8aa3b, v64
    v_mul_f32 v69, 0xbfb8aa3b, v65
    v_exp_f32 v68, v68
    v_exp_f32 v69, v69
    v_lshlrev_b32 v66, 16, v67
    v_add_f32 v68, 1.0, v68
    v_add_f32 v69, 1.0, v69
    v_rcp_f32 v68, v68
    v_rcp_f32 v69, v69
    v_and_b32 v67, 0xffff0000, v67
    v_pk_mul_f32 v[68:69], v[64:65], v[68:69]
    v_cvt_pk_bf16_f32 v69, v68, v69
    v_lshlrev_b32 v68, 16, v69
    v_and_b32 v69, 0xffff0000, v69
    v_pk_mul_f32 v[68:69], v[68:69], v[66:67]
    v_cvt_pk_bf16_f32 v68, v68, v69
    ds_write_b16 v6, v68
    ds_write_b16_d16_hi v6, v68 offset:512
    s_mov_b64 exec, s[60:61]
    s_waitcnt lgkmcnt(0)
    s_barrier
    ds_read_b128 v[96:99], v1 offset:0
    ds_read_b128 v[100:103], v1 offset:128
    ds_read_b128 v[104:107], v1 offset:256
    ds_read_b128 v[108:111], v1 offset:384
    ds_read_b128 v[112:115], v1 offset:512
    ds_read_b128 v[116:119], v1 offset:640
    ds_read_b128 v[120:123], v1 offset:768
    s_mov_b64 exec, -1
    s_waitcnt lgkmcnt(6)
    v_mfma_f32_16x16x32_bf16 v[16:19], v[96:99], v[32:35], 0
    s_waitcnt lgkmcnt(5)
    v_mfma_f32_16x16x32_bf16 v[16:19], v[100:103], v[36:39], v[16:19]
    s_waitcnt lgkmcnt(4)
    v_mfma_f32_16x16x32_bf16 v[16:19], v[104:107], v[40:43], v[16:19]
    s_waitcnt lgkmcnt(3)
    v_mfma_f32_16x16x32_bf16 v[16:19], v[108:111], v[44:47], v[16:19]
    s_waitcnt lgkmcnt(2)
    v_mfma_f32_16x16x32_bf16 v[16:19], v[112:115], v[48:51], v[16:19]
    s_waitcnt lgkmcnt(1)
    v_mfma_f32_16x16x32_bf16 v[16:19], v[116:119], v[52:55], v[16:19]
    s_waitcnt lgkmcnt(0)
    v_mfma_f32_16x16x32_bf16 v[16:19], v[120:123], v[56:59], v[16:19]
    s_mov_b32 exec_hi, 0
    s_sub_u32 s53, s51, 24
    s_cmp_lg_u32 s3, 0
    v_mov_b32 v31, s14
    s_nop 3
    v_perm_b32 v28, v16, v19, s48
    v_perm_b32 v29, v17, v19, s49
    v_perm_b32 v30, v18, v19, s50
    buffer_store_dwordx4 v[28:31], v0, s[44:47], s33 offen
    s_cbranch_scc1 L_park
    s_mov_b64 exec, -1
    buffer_load_dwordx4 v[40:43], v15, s[44:47], s18 offen sc1
    buffer_load_dwordx4 v[44:47], v15, s[44:47], s18 offen offset:1024 sc1
L_r:
    s_cmp_eq_u32 s51, s53
    s_cbranch_scc1 L_rsw
    buffer_load_dwordx4 v[48:51], v15, s[44:47], s18 offen sc1
    buffer_load_dwordx4 v[52:55], v15, s[44:47], s18 offen offset:1024 sc1
    s_sub_u32 s51, s51, 1
    s_cbranch_scc1 L_rd0
    s_waitcnt vmcnt(2)
    v_cmp_ne_u32 vcc, s14, v43
    v_cmp_ne_u32 s[56:57], s14, v47
    s_or_b64 vcc, vcc, s[56:57]
    s_cbranch_scc0 L_rd0
    buffer_load_dwordx4 v[40:43], v15, s[44:47], s18 offen sc1
    buffer_load_dwordx4 v[44:47], v15, s[44:47], s18 offen offset:1024 sc1
    s_waitcnt vmcnt(2)
    v_cmp_ne_u32 vcc, s14, v51
    v_cmp_ne_u32 s[56:57], s14, v55
    s_or_b64 vcc, vcc, s[56:57]
    s_cbranch_scc1 L_r
L_rd1:
    v_perm_b32 v51, v49, v48, s52
    v_perm_b32 v55, v53, v52, s52
    v_lshl_or_b32 v51, v50, 24, v51
    v_lshl_or_b32 v55, v54, 24, v55
    v_pk_add_f32 v[32:33], v[48:49], v[52:53]
    v_pk_add_f32 v[34:35], v[50:51], v[54:55]
    s_branch L_rj
L_rd0:
    v_perm_b32 v43, v41, v40, s52
    v_perm_b32 v47, v45, v44, s52
    v_lshl_or_b32 v43, v42, 24, v43
    v_lshl_or_b32 v47, v46, 24, v47
    v_pk_add_f32 v[32:33], v[40:41], v[44:45]
    v_pk_add_f32 v[34:35], v[42:43], v[46:47]
L_rj:
    s_nop 1
    v_permlane32_swap_b32 v32, v34
    v_permlane32_swap_b32 v33, v35
    v_pk_add_f32 v[32:33], v[32:33], v[34:35]
    s_nop 1
    v_permlane16_swap_b32 v32, v33
    v_add_f32 v32, v32, v33
    s_nop 1
    v_add_f32_dpp v32, v32, v32 row_ror:8 row_mask:0xf bank_mask:0xf
    s_nop 1
    v_add_f32_dpp v32, v32, v32 row_ror:4 row_mask:0xf bank_mask:0xf
    v_cvt_pk_bf16_f32 v32, v32, v32
    buffer_store_short v32, v5, s[40:43], s19 offen
    s_cmp_lg_u32 s2, 0
    s_cbranch_scc1 L_end
    s_add_u32 s34, s34, 31
    v_mov_b32 v25, 0
    v_mov_b32 v24, s34
    buffer_store_dword v24, v25, s[44:47], 0 offen
L_end:
    s_endpgm
L_park:
    s_lshl_b32 s28, s3, 9
    s_add_u32 s28, s28, 72704
    v_add_u32 v20, s28, v15
    ds_write_b128 v20, v[28:31]
    s_waitcnt lgkmcnt(0)
    s_endpgm
L_g:
    buffer_load_dwordx4 v[64:67], v3, s[44:47], s4 offen sc1
    s_cmp_eq_u32 s5, 0
    buffer_load_dwordx4 v[72:75], v3, s[44:47], s6 offen sc1
    s_cbranch_scc1 L_ska1
    buffer_load_dwordx4 v[68:71], v3, s[44:47], s5 offen sc1
L_ska1:
    s_cmp_eq_u32 s7, 0
    s_cbranch_scc1 L_skb1
    buffer_load_dwordx4 v[76:79], v3, s[44:47], s7 offen sc1
L_skb1:
    s_sub_u32 s51, s51, 1
    s_waitcnt vmcnt(0)
    s_cbranch_scc0 L_gchk
    s_mov_b32 s51, 0
    s_branch L_gdone
L_rsw:
    s_waitcnt vmcnt(0)
    s_mov_b32 exec_hi, 0
    s_add_u32 s54, s33, 1044480
    v_mov_b32 v31, s34
    buffer_store_dwordx4 v[28:31], v0, s[44:47], s54 offen sc1
    s_barrier
    v_add_u32 v20, 72704, v15
    ds_read_b128 v[24:27], v20 offset:512
    s_add_u32 s54, s54, 16384
    s_waitcnt lgkmcnt(0)
    v_mov_b32 v27, s34
    buffer_store_dwordx4 v[24:27], v0, s[44:47], s54 offen sc1
    s_waitcnt vmcnt(0)
    ds_read_b128 v[24:27], v20 offset:1024
    s_add_u32 s54, s54, 16384
    s_waitcnt lgkmcnt(0)
    v_mov_b32 v27, s34
    buffer_store_dwordx4 v[24:27], v0, s[44:47], s54 offen sc1
    s_waitcnt vmcnt(0)
    ds_read_b128 v[24:27], v20 offset:1536
    s_add_u32 s54, s54, 16384
    s_waitcnt lgkmcnt(0)
    v_mov_b32 v27, s34
    buffer_store_dwordx4 v[24:27], v0, s[44:47], s54 offen sc1
    s_waitcnt vmcnt(0)
    s_mov_b64 exec, -1
    s_add_u32 s28, s18, 1044480
    s_xor_b32 s28, s28, s18
    s_xor_b32 s29, s14, s34
L_slow:
    s_xor_b32 s18, s18, s28
    s_xor_b32 s14, s14, s29
    buffer_load_dwordx4 v[40:43], v15, s[44:47], s18 offen sc1
    buffer_load_dwordx4 v[44:47], v15, s[44:47], s18 offen offset:1024 sc1
    s_sub_u32 s51, s51, 1
    s_cbranch_scc1 L_rd0
    s_waitcnt vmcnt(0)
    v_cmp_ne_u32 vcc, s14, v43
    v_cmp_ne_u32 s[56:57], s14, v47
    s_or_b64 vcc, vcc, s[56:57]
    s_cbranch_scc1 L_slow
L_last:
    s_branch L_rd0
.section .rodata,"a"
.p2align 6
.amdhsa_kernel standalone__swiglu_ffn__decode_kernel
  .amdhsa_next_free_vgpr 128
  .amdhsa_next_free_sgpr 96
  .amdhsa_accum_offset 128
  .amdhsa_group_segment_fixed_size 0
  .amdhsa_kernarg_size 56
  .amdhsa_user_sgpr_count 2
  .amdhsa_user_sgpr_kernarg_segment_ptr 1
  .amdhsa_system_sgpr_workgroup_id_x 1
  .amdhsa_float_denorm_mode_32 3
.end_amdhsa_kernel
```
